```python
import torch

def _softmax(x, axis=-1):
    return torch.softmax(x, dim=axis)
def _gelu(x):
    return torch.nn.functional.gelu(x, approximate="tanh")
def _silu(x):
    return torch.nn.functional.silu(x)
def _sigmoid(x):
    return torch.sigmoid(x)
def _layernorm(x, axis=-1, eps=1e-5):
    m = x.mean(dim=axis, keepdim=True)
    v = x.var(dim=axis, keepdim=True, unbiased=False)
    return (x - m) / torch.sqrt(v + eps)
def _scatter_add(tgt, idx, src, axis=0):
    return tgt.clone().index_add_(axis, idx, src)
def _segment_sum(src, seg, n):
    out = torch.zeros((n,) + src.shape[1:], dtype=src.dtype)
    return out.index_add_(0, seg, src)
def _pad(x, pw):
    flat = tuple(v for pair in reversed(pw) for v in pair)
    return torch.nn.functional.pad(x, flat)

kernel_name = 'gated_mix__mha_block_cached__sliding_block_cached__decode'

def setup_inputs():

    _w = (lambda a: (lambda t: t.to(torch.bfloat16) if t.is_floating_point() else t)(torch.as_tensor(a)))
    def _A_setup():
        B, Sq, D = 4, 1, 512
        H, Sk, Dh = 32, 4096, 128
        return {
            "x": _w((lambda *s: torch.randn(*s, dtype=torch.bfloat16) * 0.05)(B, Sq, D)),
            "k_cache": _w((lambda *s: torch.randn(*s, dtype=torch.bfloat16) * 6.4)(B, H, Sk, Dh)),
            "v_cache": _w((lambda *s: torch.randn(*s, dtype=torch.bfloat16) * 0.05)(B, H, Sk, Dh)),
            "wq": _w((lambda *s: torch.randn(*s, dtype=torch.bfloat16) * 6.4)(D, H * Dh) * (D ** -0.5)),
            "wo": _w((lambda *s: torch.randn(*s, dtype=torch.bfloat16) * 0.05)(H * Dh, D) * ((H * Dh) ** -0.5)),
        }
    _A_in = _A_setup()

    def _B_setup():
        B, Sq, D = 4, 1, 512
        Hq, Hkv, Sk, Dh = 32, 32, 4096, 128
        assert Hq % Hkv == 0, (Hq, Hkv)
        return {
            "x": _w((lambda *s: torch.randn(*s, dtype=torch.bfloat16) * 0.05)(B, Sq, D)),
            "k_cache": _w((lambda *s: torch.randn(*s, dtype=torch.bfloat16) * 6.4)(B, Hkv, Sk, Dh)),
            "v_cache": _w((lambda *s: torch.randn(*s, dtype=torch.bfloat16) * 0.05)(B, Hkv, Sk, Dh)),
            "wq": _w((lambda *s: torch.randn(*s, dtype=torch.bfloat16) * 6.4)(D, Hq * Dh) * (D ** -0.5)),
            "wo": _w((lambda *s: torch.randn(*s, dtype=torch.bfloat16) * 0.05)(Hq * Dh, D) * ((Hq * Dh) ** -0.5)),
        }
    _B_in = _B_setup()

    return {
        "A_x": _A_in["x"],
        "A_k_cache": _A_in["k_cache"],
        "A_v_cache": _A_in["v_cache"],
        "A_wq": _A_in["wq"],
        "A_wo": _A_in["wo"],
        "B_x": _B_in["x"],
        "B_k_cache": _B_in["k_cache"],
        "B_v_cache": _B_in["v_cache"],
        "B_wq": _B_in["wq"],
        "B_wo": _B_in["wo"],
        "gate_w": _w((lambda *s: torch.randn(*s, dtype=torch.bfloat16) * 0.1)(512) * 16.0),
    }

def reference(A_x, A_k_cache, A_v_cache, A_wq, A_wo, B_x, B_k_cache, B_v_cache, B_wq, B_wo, gate_w):
    def _A_ref(x, k_cache, v_cache, wq, wo):
        B, Sq, D = x.shape
        H, Dh = 32, 128
        q = (lambda x, *d: x.permute(*d))((x @ wq).reshape(B, Sq, H, Dh), 0, 2, 1, 3)
        scores = torch.einsum("bhqd,bhkd->bhqk", q, k_cache) * (Dh ** -0.5)
        p = _softmax(scores, axis=-1)
        o = torch.einsum("bhqk,bhkd->bhqd", p, v_cache)
        return (lambda x, *d: x.permute(*d))(o, 0, 2, 1, 3).reshape(B, Sq, H * Dh) @ wo

    def _B_ref(x, k_cache, v_cache, wq, wo):
        B, Sq, D = x.shape
        Hq, Dh = 32, 128
        Hkv, Sk = k_cache.shape[1], k_cache.shape[2]
        W = min(4096, max(256, Sk // 4))
        rep = Hq // Hkv
        q = (lambda x, *d: x.permute(*d))((x @ wq).reshape(B, Sq, Hq, Dh), 0, 2, 1, 3)
        k = (lambda x, n, axis: torch.repeat_interleave(x, n, dim=axis))(k_cache[:, :, Sk - W:, :], rep, axis=1)
        v = (lambda x, n, axis: torch.repeat_interleave(x, n, dim=axis))(v_cache[:, :, Sk - W:, :], rep, axis=1)
        scores = torch.einsum("bhqd,bhkd->bhqk", q, k) * (Dh ** -0.5)
        p = _softmax(scores, axis=-1)
        o = torch.einsum("bhqk,bhkd->bhqd", p, v)
        return (lambda x, *d: x.permute(*d))(o, 0, 2, 1, 3).reshape(B, Sq, Hq * Dh) @ wo

    x = A_x
    g = _sigmoid((x * gate_w).sum(-1, keepdims=True))
    a = _A_ref(x, A_k_cache, A_v_cache, A_wq, A_wo)
    b = _B_ref(x, B_k_cache, B_v_cache, B_wq, B_wo)
    return g * a + (1 - g) * b
```

```asm
; @launch grid=(256,1,1) block=(512,1,1) lds=13312
.amdgcn_target "amdgcn-amd-amdhsa--gfx950"
.text
.globl gated_mix__mha_block_cached__sliding_block_cached__decode_kernel
.p2align 8
.type gated_mix__mha_block_cached__sliding_block_cached__decode_kernel,@function
gated_mix__mha_block_cached__sliding_block_cached__decode_kernel:
    s_cmp_ge_u32 s2, 256
    s_cbranch_scc1 L_end
    s_load_dwordx16 s[16:31], s[0:1], 0
    s_load_dwordx8 s[32:39], s[0:1], 64
    s_load_dwordx4 s[40:43], s[0:1], 96
    v_and_b32 v1, 63, v0
    v_lshrrev_b32 v28, 6, v0
    s_nop 0
    v_readfirstlane_b32 s3, v28
    s_lshr_b32 s11, s2, 3
    s_and_b32 s12, s11, 3
    s_lshr_b32 s6, s11, 2
    s_and_b32 s6, s6, 1
    s_lshr_b32 s5, s11, 3
    s_mul_i32 s11, s6, 5
    s_xor_b32 s11, s11, s2
    s_and_b32 s11, s11, 7
    s_lshl_b32 s11, s11, 2
    s_add_u32 s4, s11, s12
    s_lshl_b32 s61, s5, 5
    s_add_u32 s61, s61, s4
    s_lshl_b32 s96, s61, 20
    s_mul_i32 s12, s6, 786432
    s_add_u32 s90, s96, s12
    v_lshlrev_b32 v2, 4, v1
    v_lshrrev_b32 v28, 4, v1
    v_bfe_u32 v29, v1, 3, 1
    v_and_b32 v30, 7, v1
    v_lshl_add_u32 v31, v29, 2, v28
    v_lshlrev_b32 v31, 8, v31
    v_lshl_add_u32 v3, v30, 4, v31
    v_lshrrev_b32 v60, 3, v1
    v_lshlrev_b32 v61, 5, v60
    v_lshlrev_b32 v62, 17, v60
    v_lshl_add_u32 v62, v30, 4, v62
    s_cmp_eq_u32 s6, 0
    s_waitcnt lgkmcnt(0)
    s_cselect_b32 s44, s18, s28
    s_cselect_b32 s45, s19, s29
    s_cselect_b32 s48, s20, s30
    s_cselect_b32 s49, s21, s31
    s_cselect_b32 s56, s22, s32
    s_cselect_b32 s57, s23, s33
    s_cselect_b32 s60, 32, 32
    s_mov_b32 s46, 134217728
    s_mov_b32 s47, 0x00020000
    s_mov_b32 s50, 134217728
    s_mov_b32 s51, 0x00020000
    s_mov_b32 s58, 4194304
    s_mov_b32 s59, 0x00020000
    s_mov_b32 s52, s16
    s_mov_b32 s53, s17
    s_mov_b32 s54, 4096
    s_mov_b32 s55, 0x00020000
    s_mov_b32 s72, s36
    s_mov_b32 s73, s37
    s_mov_b32 s74, 1024
    s_mov_b32 s75, 0x00020000
    s_lshl_b32 s11, s5, 10
    buffer_load_dwordx4 v[44:47], v2, s[52:55], s11 offen
    buffer_load_dwordx4 v[48:51], v2, s[72:75], 0 offen
    s_cmp_ge_u32 s3, 4
    s_cbranch_scc1 L_pro_kv
    s_lshl_b32 s12, s3, 8
    s_add_u32 s11, s11, s12
    buffer_load_dwordx4 v[52:55], v61, s[52:55], s11 offen
    buffer_load_dwordx4 v[16:19], v61, s[52:55], s11 offen offset:16
    s_lshl_b32 s11, s3, 20
    s_lshl_b32 s12, s4, 8
    s_add_u32 s11, s11, s12
    buffer_load_dwordx4 v[64:67], v62, s[56:59], s11 offen offset:0
    buffer_load_dwordx4 v[68:71], v62, s[56:59], s11 offen offset:128
    s_add_u32 s11, s11, 8192
    buffer_load_dwordx4 v[72:75], v62, s[56:59], s11 offen offset:0
    buffer_load_dwordx4 v[76:79], v62, s[56:59], s11 offen offset:128
    s_add_u32 s11, s11, 8192
    buffer_load_dwordx4 v[80:83], v62, s[56:59], s11 offen offset:0
    buffer_load_dwordx4 v[84:87], v62, s[56:59], s11 offen offset:128
    s_add_u32 s11, s11, 8192
    buffer_load_dwordx4 v[88:91], v62, s[56:59], s11 offen offset:0
    buffer_load_dwordx4 v[92:95], v62, s[56:59], s11 offen offset:128
    s_add_u32 s11, s11, 8192
    buffer_load_dwordx4 v[96:99], v62, s[56:59], s11 offen offset:0
    buffer_load_dwordx4 v[100:103], v62, s[56:59], s11 offen offset:128
    s_add_u32 s11, s11, 8192
    buffer_load_dwordx4 v[104:107], v62, s[56:59], s11 offen offset:0
    buffer_load_dwordx4 v[108:111], v62, s[56:59], s11 offen offset:128
    s_add_u32 s11, s11, 8192
    buffer_load_dwordx4 v[112:115], v62, s[56:59], s11 offen offset:0
    buffer_load_dwordx4 v[116:119], v62, s[56:59], s11 offen offset:128
    s_add_u32 s11, s11, 8192
    buffer_load_dwordx4 v[120:123], v62, s[56:59], s11 offen offset:0
    buffer_load_dwordx4 v[124:127], v62, s[56:59], s11 offen offset:128
    s_add_u32 s11, s11, 8192
    buffer_load_dwordx4 v[128:131], v62, s[56:59], s11 offen offset:0
    buffer_load_dwordx4 v[132:135], v62, s[56:59], s11 offen offset:128
    s_add_u32 s11, s11, 8192
    buffer_load_dwordx4 v[136:139], v62, s[56:59], s11 offen offset:0
    buffer_load_dwordx4 v[140:143], v62, s[56:59], s11 offen offset:128
    s_add_u32 s11, s11, 8192
    buffer_load_dwordx4 v[144:147], v62, s[56:59], s11 offen offset:0
    buffer_load_dwordx4 v[148:151], v62, s[56:59], s11 offen offset:128
    s_add_u32 s11, s11, 8192
    buffer_load_dwordx4 v[152:155], v62, s[56:59], s11 offen offset:0
    buffer_load_dwordx4 v[156:159], v62, s[56:59], s11 offen offset:128
    s_add_u32 s11, s11, 8192
    buffer_load_dwordx4 v[160:163], v62, s[56:59], s11 offen offset:0
    buffer_load_dwordx4 v[164:167], v62, s[56:59], s11 offen offset:128
    s_add_u32 s11, s11, 8192
    buffer_load_dwordx4 v[168:171], v62, s[56:59], s11 offen offset:0
    buffer_load_dwordx4 v[172:175], v62, s[56:59], s11 offen offset:128
    s_add_u32 s11, s11, 8192
    buffer_load_dwordx4 v[176:179], v62, s[56:59], s11 offen offset:0
    buffer_load_dwordx4 v[180:183], v62, s[56:59], s11 offen offset:128
    s_add_u32 s11, s11, 8192
    buffer_load_dwordx4 v[184:187], v62, s[56:59], s11 offen offset:0
    buffer_load_dwordx4 v[188:191], v62, s[56:59], s11 offen offset:128
    s_branch L_pro_join
L_pro_kv:
    s_sub_u32 s99, s3, 4
    s_lshl_b32 s12, s99, 13
    s_add_u32 s8, s90, s12
    s_add_u32 s9, s8, 4096
    buffer_load_dwordx4 v[128:131], v2, s[44:47], s8 offen offset:0 nt
    buffer_load_dwordx4 v[132:135], v2, s[44:47], s8 offen offset:1024 nt
    buffer_load_dwordx4 v[136:139], v2, s[44:47], s8 offen offset:2048 nt
    buffer_load_dwordx4 v[140:143], v2, s[44:47], s8 offen offset:3072 nt
    buffer_load_dwordx4 v[144:147], v2, s[44:47], s9 offen offset:0 nt
    buffer_load_dwordx4 v[148:151], v2, s[44:47], s9 offen offset:1024 nt
    buffer_load_dwordx4 v[152:155], v2, s[44:47], s9 offen offset:2048 nt
    buffer_load_dwordx4 v[156:159], v2, s[44:47], s9 offen offset:3072 nt
    buffer_load_dwordx4 v[160:163], v3, s[48:51], s8 offen offset:0 nt
    buffer_load_dwordx4 v[164:167], v3, s[48:51], s8 offen offset:128 nt
    buffer_load_dwordx4 v[168:171], v3, s[48:51], s8 offen offset:2048 nt
    buffer_load_dwordx4 v[172:175], v3, s[48:51], s8 offen offset:2176 nt
    buffer_load_dwordx4 v[176:179], v3, s[48:51], s9 offen offset:0 nt
    buffer_load_dwordx4 v[180:183], v3, s[48:51], s9 offen offset:128 nt
    buffer_load_dwordx4 v[184:187], v3, s[48:51], s9 offen offset:2048 nt
    buffer_load_dwordx4 v[188:191], v3, s[48:51], s9 offen offset:2176 nt
L_pro_join:
    s_mov_b32 s14, 0x3fb8aa3b
    s_mov_b32 s15, 0x3db504f3
    s_mov_b32 s88, 0x00ff00ff
    s_mov_b32 s89, 0xff00ff00
    s_mov_b32 s97, 0
    s_mov_b32 s64, s24
    s_mov_b32 s65, s25
    s_mov_b32 s66, 4194304
    s_mov_b32 s67, 0x00020000
    s_mov_b32 s68, s34
    s_mov_b32 s69, s35
    s_mov_b32 s70, 4194304
    s_mov_b32 s71, 0x00020000
    s_mov_b32 s76, s38
    s_mov_b32 s77, s39
    s_mov_b32 s78, 4096
    s_mov_b32 s79, 0x00020000
    s_mov_b32 s80, s40
    s_mov_b32 s81, s41
    s_mov_b32 s82, 256
    s_mov_b32 s83, 0x00020000
    s_mov_b32 s84, s42
    s_mov_b32 s85, s43
    s_mov_b32 s86, 821248
    s_mov_b32 s87, 0x00020000
    s_and_b32 s24, s3, 3
    s_lshl_b32 s25, s4, 17
    s_lshl_b32 s12, s24, 8
    s_add_u32 s25, s25, s12
    s_mov_b32 s22, s44
    s_mov_b32 s23, s45
    s_mov_b32 s26, s48
    s_mov_b32 s27, s49
    s_mul_i32 s11, s61, 256
    s_add_u32 s11, s11, 9209856
    s_add_u32 s16, s42, s11
    s_addc_u32 s17, s43, 0
    s_lshl_b32 s11, s5, 3
    s_add_u32 s11, s11, 128
    s_add_u32 s32, s40, s11
    s_addc_u32 s33, s41, 0
    v_lshrrev_b32 v28, 4, v1
    v_and_b32 v30, 7, v1
    v_lshrrev_b32 v31, 1, v28
    v_lshlrev_b32 v31, 9, v31
    v_lshl_add_u32 v31, v30, 5, v31
    v_and_b32 v29, 1, v28
    v_lshl_add_u32 v31, v29, 4, v31
    s_lshl_b32 s11, s24, 10
    v_add_u32 v56, s11, v31
    v_lshlrev_b32 v63, 14, v60
    v_lshl_add_u32 v63, v30, 4, v63
    v_mov_b32 v28, 8768
    v_mov_b32 v29, 4
    v_mov_b32 v30, 0
    s_cmp_lg_u32 s3, 7
    s_cbranch_scc1 L_cnt_done
    s_mov_b64 exec, 1
    ds_write_b32 v28, v29
    ds_write_b32 v28, v30 offset:4
    ds_write_b32 v28, v30 offset:8
    ds_write_b32 v28, v30 offset:16
    s_mov_b64 exec, -1
L_cnt_done:
    v_and_b32 v28, 1, v1
    v_bfe_u32 v29, v1, 1, 2
    v_cmp_eq_u32 vcc, 1, v28
    v_mov_b32 v30, 0x0c0c0100
    v_mov_b32 v31, 0x01000c0c
    v_mov_b32 v60, 0x0c0c0302
    v_mov_b32 v61, 0x03020c0c
    v_cndmask_b32 v30, v30, v31, vcc
    v_cndmask_b32 v31, v60, v61, vcc
    v_mov_b32 v60, 0x0c0c0c0c
    v_cmp_eq_u32 vcc, 0, v29
    s_nop 1
    v_cndmask_b32 v4, v60, v30, vcc
    v_cndmask_b32 v8, v60, v31, vcc
    v_cmp_eq_u32 vcc, 1, v29
    s_nop 1
    v_cndmask_b32 v5, v60, v30, vcc
    v_cndmask_b32 v9, v60, v31, vcc
    v_cmp_eq_u32 vcc, 2, v29
    s_nop 1
    v_cndmask_b32 v6, v60, v30, vcc
    v_cndmask_b32 v10, v60, v31, vcc
    v_cmp_eq_u32 vcc, 3, v29
    s_nop 1
    v_cndmask_b32 v7, v60, v30, vcc
    v_cndmask_b32 v11, v60, v31, vcc
    s_waitcnt vmcnt(16)
    v_mov_b32 v62, 0
    v_lshlrev_b32 v28, 16, v44
    v_and_b32 v29, 0xffff0000, v44
    v_lshlrev_b32 v30, 16, v48
    v_and_b32 v31, 0xffff0000, v48
    v_mul_f32 v28, v28, v30
    v_mul_f32 v29, v29, v31
    v_cvt_pk_bf16_f32 v28, v28, v29
    v_lshlrev_b32 v29, 16, v28
    v_and_b32 v28, 0xffff0000, v28
    v_add_f32 v62, v62, v29
    v_add_f32 v62, v62, v28
    v_lshlrev_b32 v28, 16, v45
    v_and_b32 v29, 0xffff0000, v45
    v_lshlrev_b32 v30, 16, v49
    v_and_b32 v31, 0xffff0000, v49
    v_mul_f32 v28, v28, v30
    v_mul_f32 v29, v29, v31
    v_cvt_pk_bf16_f32 v28, v28, v29
    v_lshlrev_b32 v29, 16, v28
    v_and_b32 v28, 0xffff0000, v28
    v_add_f32 v62, v62, v29
    v_add_f32 v62, v62, v28
    v_lshlrev_b32 v28, 16, v46
    v_and_b32 v29, 0xffff0000, v46
    v_lshlrev_b32 v30, 16, v50
    v_and_b32 v31, 0xffff0000, v50
    v_mul_f32 v28, v28, v30
    v_mul_f32 v29, v29, v31
    v_cvt_pk_bf16_f32 v28, v28, v29
    v_lshlrev_b32 v29, 16, v28
    v_and_b32 v28, 0xffff0000, v28
    v_add_f32 v62, v62, v29
    v_add_f32 v62, v62, v28
    v_lshlrev_b32 v28, 16, v47
    v_and_b32 v29, 0xffff0000, v47
    v_lshlrev_b32 v30, 16, v51
    v_and_b32 v31, 0xffff0000, v51
    v_mul_f32 v28, v28, v30
    v_mul_f32 v29, v29, v31
    v_cvt_pk_bf16_f32 v28, v28, v29
    v_lshlrev_b32 v29, 16, v28
    v_and_b32 v28, 0xffff0000, v28
    v_add_f32 v62, v62, v29
    v_add_f32 v62, v62, v28
    s_nop 1
    v_add_f32_dpp v62, v62, v62 row_ror:8 row_mask:0xf bank_mask:0xf
    s_nop 1
    v_add_f32_dpp v62, v62, v62 row_ror:4 row_mask:0xf bank_mask:0xf
    s_nop 1
    v_add_f32_dpp v62, v62, v62 row_ror:2 row_mask:0xf bank_mask:0xf
    s_nop 1
    v_add_f32_dpp v62, v62, v62 row_ror:1 row_mask:0xf bank_mask:0xf
    s_nop 1
    v_add_f32_dpp v62, v62, v62 row_bcast:15 row_mask:0xa bank_mask:0xf
    s_nop 1
    v_add_f32_dpp v62, v62, v62 row_bcast:31 row_mask:0xc bank_mask:0xf
    v_cvt_pk_bf16_f32 v28, v62, v62
    v_lshlrev_b32 v28, 16, v28
    v_mul_f32 v28, 0xbfb8aa3b, v28
    v_exp_f32 v28, v28
    s_nop 0
    v_add_f32 v28, 1.0, v28
    v_rcp_f32 v28, v28
    s_nop 0
    v_cvt_pk_bf16_f32 v28, v28, v28
    v_lshlrev_b32 v28, 16, v28
    v_sub_f32 v29, 1.0, v28
    v_cvt_pk_bf16_f32 v29, v29, v29
    v_lshlrev_b32 v29, 16, v29
    s_nop 0
    v_readlane_b32 s93, v28, 63
    v_readlane_b32 s94, v29, 63
    s_cmp_ge_u32 s3, 4
    s_cbranch_scc1 L_q_bar1
    v_perm_b32 v44, v52, v52, v4
    v_perm_b32 v45, v52, v52, v5
    v_perm_b32 v46, v52, v52, v6
    v_perm_b32 v47, v52, v52, v7
    s_waitcnt vmcnt(24)
    v_perm_b32 v48, v52, v52, v8
    v_perm_b32 v49, v52, v52, v9
    v_perm_b32 v50, v52, v52, v10
    v_perm_b32 v51, v52, v52, v11
    v_mfma_f32_16x16x32_bf16 v[32:35], v[44:47], v[64:67], 0
    v_mfma_f32_16x16x32_bf16 v[36:39], v[44:47], v[68:71], 0
    v_perm_b32 v44, v53, v53, v4
    v_perm_b32 v45, v53, v53, v5
    v_perm_b32 v46, v53, v53, v6
    v_perm_b32 v47, v53, v53, v7
    v_mfma_f32_16x16x32_bf16 v[32:35], v[48:51], v[72:75], v[32:35]
    v_mfma_f32_16x16x32_bf16 v[36:39], v[48:51], v[76:79], v[36:39]
    v_perm_b32 v48, v53, v53, v8
    v_perm_b32 v49, v53, v53, v9
    v_perm_b32 v50, v53, v53, v10
    v_perm_b32 v51, v53, v53, v11
    v_mfma_f32_16x16x32_bf16 v[32:35], v[44:47], v[80:83], v[32:35]
    v_mfma_f32_16x16x32_bf16 v[36:39], v[44:47], v[84:87], v[36:39]
    v_perm_b32 v44, v54, v54, v4
    v_perm_b32 v45, v54, v54, v5
    v_perm_b32 v46, v54, v54, v6
    v_perm_b32 v47, v54, v54, v7
    v_mfma_f32_16x16x32_bf16 v[32:35], v[48:51], v[88:91], v[32:35]
    v_mfma_f32_16x16x32_bf16 v[36:39], v[48:51], v[92:95], v[36:39]
    s_waitcnt vmcnt(16)
    v_perm_b32 v48, v54, v54, v8
    v_perm_b32 v49, v54, v54, v9
    v_perm_b32 v50, v54, v54, v10
    v_perm_b32 v51, v54, v54, v11
    v_mfma_f32_16x16x32_bf16 v[32:35], v[44:47], v[96:99], v[32:35]
    v_mfma_f32_16x16x32_bf16 v[36:39], v[44:47], v[100:103], v[36:39]
    v_perm_b32 v44, v55, v55, v4
    v_perm_b32 v45, v55, v55, v5
    v_perm_b32 v46, v55, v55, v6
    v_perm_b32 v47, v55, v55, v7
    v_mfma_f32_16x16x32_bf16 v[32:35], v[48:51], v[104:107], v[32:35]
    v_mfma_f32_16x16x32_bf16 v[36:39], v[48:51], v[108:111], v[36:39]
    v_perm_b32 v48, v55, v55, v8
    v_perm_b32 v49, v55, v55, v9
    v_perm_b32 v50, v55, v55, v10
    v_perm_b32 v51, v55, v55, v11
    v_mfma_f32_16x16x32_bf16 v[32:35], v[44:47], v[112:115], v[32:35]
    v_mfma_f32_16x16x32_bf16 v[36:39], v[44:47], v[116:119], v[36:39]
    v_perm_b32 v44, v16, v16, v4
    v_perm_b32 v45, v16, v16, v5
    v_perm_b32 v46, v16, v16, v6
    v_perm_b32 v47, v16, v16, v7
    v_mfma_f32_16x16x32_bf16 v[32:35], v[48:51], v[120:123], v[32:35]
    v_mfma_f32_16x16x32_bf16 v[36:39], v[48:51], v[124:127], v[36:39]
    s_waitcnt vmcnt(8)
    v_perm_b32 v48, v16, v16, v8
    v_perm_b32 v49, v16, v16, v9
    v_perm_b32 v50, v16, v16, v10
    v_perm_b32 v51, v16, v16, v11
    v_mfma_f32_16x16x32_bf16 v[32:35], v[44:47], v[128:131], v[32:35]
    v_mfma_f32_16x16x32_bf16 v[36:39], v[44:47], v[132:135], v[36:39]
    v_perm_b32 v44, v17, v17, v4
    v_perm_b32 v45, v17, v17, v5
    v_perm_b32 v46, v17, v17, v6
    v_perm_b32 v47, v17, v17, v7
    v_mfma_f32_16x16x32_bf16 v[32:35], v[48:51], v[136:139], v[32:35]
    v_mfma_f32_16x16x32_bf16 v[36:39], v[48:51], v[140:143], v[36:39]
    v_perm_b32 v48, v17, v17, v8
    v_perm_b32 v49, v17, v17, v9
    v_perm_b32 v50, v17, v17, v10
    v_perm_b32 v51, v17, v17, v11
    v_mfma_f32_16x16x32_bf16 v[32:35], v[44:47], v[144:147], v[32:35]
    v_mfma_f32_16x16x32_bf16 v[36:39], v[44:47], v[148:151], v[36:39]
    v_perm_b32 v44, v18, v18, v4
    v_perm_b32 v45, v18, v18, v5
    v_perm_b32 v46, v18, v18, v6
    v_perm_b32 v47, v18, v18, v7
    v_mfma_f32_16x16x32_bf16 v[32:35], v[48:51], v[152:155], v[32:35]
    v_mfma_f32_16x16x32_bf16 v[36:39], v[48:51], v[156:159], v[36:39]
    s_waitcnt vmcnt(0)
    v_perm_b32 v48, v18, v18, v8
    v_perm_b32 v49, v18, v18, v9
    v_perm_b32 v50, v18, v18, v10
    v_perm_b32 v51, v18, v18, v11
    v_mfma_f32_16x16x32_bf16 v[32:35], v[44:47], v[160:163], v[32:35]
    v_mfma_f32_16x16x32_bf16 v[36:39], v[44:47], v[164:167], v[36:39]
    v_perm_b32 v44, v19, v19, v4
    v_perm_b32 v45, v19, v19, v5
    v_perm_b32 v46, v19, v19, v6
    v_perm_b32 v47, v19, v19, v7
    v_mfma_f32_16x16x32_bf16 v[32:35], v[48:51], v[168:171], v[32:35]
    v_mfma_f32_16x16x32_bf16 v[36:39], v[48:51], v[172:175], v[36:39]
    v_perm_b32 v48, v19, v19, v8
    v_perm_b32 v49, v19, v19, v9
    v_perm_b32 v50, v19, v19, v10
    v_perm_b32 v51, v19, v19, v11
    v_mfma_f32_16x16x32_bf16 v[32:35], v[44:47], v[176:179], v[32:35]
    v_mfma_f32_16x16x32_bf16 v[36:39], v[44:47], v[180:183], v[36:39]
    s_nop 1
    v_mfma_f32_16x16x32_bf16 v[32:35], v[48:51], v[184:187], v[32:35]
    v_mfma_f32_16x16x32_bf16 v[36:39], v[48:51], v[188:191], v[36:39]
    s_nop 7
    s_nop 1
    s_mov_b64 exec, s[88:89]
    ds_write_b128 v56, v[32:35] offset:9216
    ds_write_b128 v56, v[36:39] offset:9472
    s_mov_b64 exec, -1
L_q_bar1:
    s_waitcnt lgkmcnt(0)
    s_barrier
    s_cmp_ge_u32 s3, 2
    s_cbranch_scc1 L_q_s1_done
    v_and_b32 v28, 127, v0
    v_lshlrev_b32 v29, 2, v28
    ds_read_b32 v64, v29 offset:9216
    ds_read_b32 v65, v29 offset:9728
    ds_read_b32 v66, v29 offset:10240
    ds_read_b32 v67, v29 offset:10752
    ds_read_b32 v68, v29 offset:11264
    ds_read_b32 v69, v29 offset:11776
    ds_read_b32 v70, v29 offset:12288
    ds_read_b32 v71, v29 offset:12800
    s_lshl_b32 s12, s6, 8
    v_lshlrev_b32 v28, 1, v28
    v_add_u32 v28, s12, v28
    s_waitcnt lgkmcnt(0)
    v_add_f32 v64, v64, v68
    v_add_f32 v65, v65, v69
    v_add_f32 v66, v66, v70
    v_add_f32 v67, v67, v71
    v_add_f32 v64, v64, v66
    v_add_f32 v65, v65, v67
    v_add_f32 v64, v64, v65
    v_cvt_pk_bf16_f32 v30, v64, v64
    ds_write_b16 v28, v30 offset:8192
L_q_s1_done:
    s_waitcnt lgkmcnt(0)
    s_barrier
    v_and_b32 v28, 15, v1
    v_lshlrev_b32 v16, 4, v28
    s_lshl_b32 s11, s6, 8
    v_add_u32 v29, s11, v16
    ds_read_b128 v[12:15], v29 offset:8192
    v_mov_b32 v52, 8768
    v_mov_b32 v53, 1
    v_mov_b32 v54, 0
    v_mov_b32 v55, v63
    v_lshlrev_b32 v17, 3, v1
    s_cmp_ge_u32 s3, 4
    s_cbranch_scc1 L_stream
    v_add_u32 v18, 40, v1
    v_and_b32 v18, 63, v18
    v_lshlrev_b32 v18, 2, v18
    v_and_b32 v19, 15, v1
    v_lshlrev_b32 v19, 5, v19
    v_lshrrev_b32 v31, 4, v1
    v_lshl_add_u32 v19, v31, 4, v19
    s_lshl_b32 s8, s61, 4
    s_lshl_b32 s12, s6, 3
    s_add_u32 s8, s8, s12
    s_add_u32 s8, s8, 786432
    s_mul_i32 s9, s5, 96
    s_add_u32 s9, s9, s4
    s_lshl_b32 s12, s6, 5
    s_add_u32 s9, s9, s12
    s_lshl_b32 s9, s9, 11
    s_lshl_b32 s12, s3, 9
    s_add_u32 s9, s9, s12
    v_and_b32 v30, 15, v1
    v_lshlrev_b32 v30, 5, v30
    v_lshrrev_b32 v31, 4, v1
    v_lshl_add_u32 v30, v31, 4, v30
    v_mov_b32 v32, -1
    v_mov_b32 v33, -1
    v_mov_b32 v34, -1
    v_mov_b32 v35, -1
    s_mul_i32 s13, s5, 96
    s_add_u32 s13, s13, s4
    s_lshl_b32 s13, s13, 11
    s_lshl_b32 s12, s3, 9
    s_add_u32 s13, s13, s12
    s_lshl_b32 s12, s6, 16
    s_add_u32 s11, s13, s12
    s_mov_b32 exec_lo, 0x00ff00ff
    s_mov_b32 exec_hi, 0
    buffer_store_dwordx4 v[32:35], v30, s[84:87], s11 offen sc1
    buffer_store_dwordx4 v[32:35], v30, s[84:87], s11 offen offset:256 sc1
    s_cmp_eq_u32 s6, 0
    s_cbranch_scc1 L_si_a
    s_add_u32 s11, s13, 131072
    buffer_store_dwordx4 v[32:35], v30, s[84:87], s11 offen sc1
    buffer_store_dwordx4 v[32:35], v30, s[84:87], s11 offen offset:256 sc1
L_si_a:
    s_mov_b64 exec, 1
    s_cmp_lg_u32 s3, 0
    s_cbranch_scc1 L_si_b
    s_lshl_b32 s11, s61, 4
    s_lshl_b32 s12, s6, 3
    s_add_u32 s11, s11, s12
    s_add_u32 s11, s11, 786432
    v_mov_b32 v28, 0
    buffer_store_dwordx2 v[32:33], v28, s[84:87], s11 offen sc1
L_si_b:
    s_waitcnt vmcnt(0)
    ds_add_u32 v52, v53 offset:16
    s_mov_b64 exec, -1
L_si_done:
    s_cmp_lg_u32 s6, 0
    s_cbranch_scc1 L_pj_t1
    s_cmp_lg_u32 s3, 3
    s_cbranch_scc1 L_pj_a
    s_lshl_b32 s11, s61, 8
    s_add_u32 s11, s11, 788480
    s_waitcnt lgkmcnt(0)
    s_mov_b64 exec, 0xffff
    buffer_store_dwordx4 v[12:15], v16, s[84:87], s11 offen sc1
    s_mov_b64 exec, -1
    s_mov_b32 s98, 32
    s_atomic_swap s98, s[16:17], 0 glc
    s_waitcnt vmcnt(0) lgkmcnt(0)
    s_mov_b64 exec, 1
    ds_write_b32 v52, v53 offset:4
    s_mov_b64 exec, -1
L_w0i:
    ds_read_b32 v54, v52 offset:16
    s_waitcnt lgkmcnt(0)
    v_readfirstlane_b32 s98, v54
    s_nop 0
    s_cmp_ge_u32 s98, 4
    s_cbranch_scc1 L_w0i_ok
    s_sleep 4
    s_branch L_w0i
L_w0i_ok:
    s_lshr_b32 s13, s2, 3
    s_and_b32 s13, s13, 3
    s_lshr_b32 s12, s2, 4
    s_and_b32 s12, s12, 4
    s_or_b32 s13, s13, s12
    s_mul_i32 s13, s13, 0
    s_add_u32 s13, s13, 0
L_w0s:
    ds_read_b32 v54, v52 offset:0
    s_waitcnt lgkmcnt(0)
    v_readfirstlane_b32 s98, v54
    s_nop 0
    s_cmp_ge_u32 s98, s13
    s_cbranch_scc1 L_w0s_ok
    s_sleep 4
    s_branch L_w0s
L_w0s_ok:
    s_lshl_b32 s98, 1, s4
    s_atomic_or s98, s[32:33], 0 glc
    s_waitcnt lgkmcnt(0)
    s_branch L_pj_a
L_pj_t1:
    s_add_u32 s11, s25, 0
    buffer_load_dwordx4 v[64:67], v55, s[68:71], s11 offen offset:0
    buffer_load_dwordx4 v[68:71], v55, s[68:71], s11 offen offset:128
    buffer_load_dwordx4 v[72:75], v55, s[68:71], s11 offen offset:1024
    buffer_load_dwordx4 v[76:79], v55, s[68:71], s11 offen offset:1152
    buffer_load_dwordx4 v[80:83], v55, s[68:71], s11 offen offset:2048
    buffer_load_dwordx4 v[84:87], v55, s[68:71], s11 offen offset:2176
    buffer_load_dwordx4 v[88:91], v55, s[68:71], s11 offen offset:3072
    buffer_load_dwordx4 v[92:95], v55, s[68:71], s11 offen offset:3200
    s_add_u32 s11, s25, 4096
    buffer_load_dwordx4 v[96:99], v55, s[68:71], s11 offen offset:0
    buffer_load_dwordx4 v[100:103], v55, s[68:71], s11 offen offset:128
    buffer_load_dwordx4 v[104:107], v55, s[68:71], s11 offen offset:1024
    buffer_load_dwordx4 v[108:111], v55, s[68:71], s11 offen offset:1152
    buffer_load_dwordx4 v[112:115], v55, s[68:71], s11 offen offset:2048
    buffer_load_dwordx4 v[116:119], v55, s[68:71], s11 offen offset:2176
    buffer_load_dwordx4 v[120:123], v55, s[68:71], s11 offen offset:3072
    buffer_load_dwordx4 v[124:127], v55, s[68:71], s11 offen offset:3200
    s_add_u32 s11, s25, 8192
    buffer_load_dwordx4 v[128:131], v55, s[68:71], s11 offen offset:0
    buffer_load_dwordx4 v[132:135], v55, s[68:71], s11 offen offset:128
    buffer_load_dwordx4 v[136:139], v55, s[68:71], s11 offen offset:1024
    buffer_load_dwordx4 v[140:143], v55, s[68:71], s11 offen offset:1152
    buffer_load_dwordx4 v[144:147], v55, s[68:71], s11 offen offset:2048
    buffer_load_dwordx4 v[148:151], v55, s[68:71], s11 offen offset:2176
    buffer_load_dwordx4 v[152:155], v55, s[68:71], s11 offen offset:3072
    buffer_load_dwordx4 v[156:159], v55, s[68:71], s11 offen offset:3200
    s_add_u32 s11, s25, 12288
    buffer_load_dwordx4 v[160:163], v55, s[68:71], s11 offen offset:0
    buffer_load_dwordx4 v[164:167], v55, s[68:71], s11 offen offset:128
    buffer_load_dwordx4 v[168:171], v55, s[68:71], s11 offen offset:1024
    buffer_load_dwordx4 v[172:175], v55, s[68:71], s11 offen offset:1152
    buffer_load_dwordx4 v[176:179], v55, s[68:71], s11 offen offset:2048
    buffer_load_dwordx4 v[180:183], v55, s[68:71], s11 offen offset:2176
    buffer_load_dwordx4 v[184:187], v55, s[68:71], s11 offen offset:3072
    buffer_load_dwordx4 v[188:191], v55, s[68:71], s11 offen offset:3200
    s_cmp_lg_u32 s3, 3
    s_cbranch_scc1 L_pj_bw
L_w1i:
    ds_read_b32 v54, v52 offset:16
    s_waitcnt lgkmcnt(0)
    v_readfirstlane_b32 s98, v54
    s_nop 0
    s_cmp_ge_u32 s98, 4
    s_cbranch_scc1 L_w1i_ok
    s_sleep 4
    s_branch L_w1i
L_w1i_ok:
    s_lshr_b32 s13, s2, 3
    s_and_b32 s13, s13, 3
    s_lshr_b32 s12, s2, 4
    s_and_b32 s12, s12, 4
    s_or_b32 s13, s13, s12
    s_mul_i32 s13, s13, 0
    s_add_u32 s13, s13, 14
L_w1s:
    ds_read_b32 v54, v52 offset:0
    s_waitcnt lgkmcnt(0)
    v_readfirstlane_b32 s98, v54
    s_nop 0
    s_cmp_ge_u32 s98, s13
    s_cbranch_scc1 L_w1s_ok
    s_sleep 4
    s_branch L_w1s
L_w1s_ok:
    s_mov_b32 s95, 0
L_fp:
    s_mov_b32 s28, 0
    s_lshl_b32 s29, 1, s4
    s_atomic_or_x2 s[28:29], s[32:33], 0 glc
    s_waitcnt lgkmcnt(0)
    s_lshr_b32 s98, s28, s4
    s_and_b32 s98, s98, 1
    s_cmp_lg_u32 s98, 0
    s_cbranch_scc1 L_fg
    s_add_u32 s95, s95, 1
    s_sleep 64
    s_cmp_lt_u32 s95, 100000
    s_cbranch_scc1 L_fp
L_fg:
    s_lshl_b32 s11, s61, 8
    s_add_u32 s11, s11, 788480
    s_mov_b64 exec, 0xffff
    buffer_load_dwordx4 v[44:47], v16, s[84:87], s11 offen sc1
    s_waitcnt vmcnt(0)
    ds_write_b128 v16, v[44:47] offset:8192
    s_waitcnt lgkmcnt(0)
    s_mov_b64 exec, 1
    ds_write_b32 v52, v53 offset:4
    s_mov_b64 exec, -1
L_pj_bw:
    ds_read_b32 v54, v52 offset:8
    s_waitcnt lgkmcnt(0)
    v_readfirstlane_b32 s98, v54
    s_nop 0
    s_cmp_ge_u32 s98, 4
    s_cbranch_scc1 L_pj_bgo
    s_sleep 8
    s_branch L_pj_bw
L_pj_bgo:
    v_mov_b32 v30, 0
    ds_read_b128 v[60:63], v30 offset:8736
    ds_read_b128 v[44:47], v30 offset:8752
    ds_read_b64 v[192:193], v17 offset:4096
    ds_read_b64 v[194:195], v17 offset:4608
    ds_read_b64 v[196:197], v17 offset:5120
    ds_read_b64 v[198:199], v17 offset:5632
    ds_read_b64 v[200:201], v17 offset:6144
    ds_read_b64 v[202:203], v17 offset:6656
    ds_read_b64 v[204:205], v17 offset:7168
    ds_read_b64 v[206:207], v17 offset:7680
    s_waitcnt lgkmcnt(8)
    v_max3_f32 v30, v60, v62, v44
    v_max_f32 v30, v46, v30
    v_max_f32 v30, 0xf149f2ca, v30
    v_mul_f32 v57, 0xbfb8aa3b, v30
    v_fma_f32 v60, v60, s14, v57
    v_fma_f32 v62, v62, s14, v57
    v_fma_f32 v44, v44, s14, v57
    v_fma_f32 v46, v46, s14, v57
    v_exp_f32 v60, v60
    v_exp_f32 v62, v62
    v_exp_f32 v44, v44
    v_exp_f32 v46, v46
    s_nop 0
    v_mul_f32 v31, v60, v61
    v_fma_f32 v31, v62, v63, v31
    v_fma_f32 v31, v44, v45, v31
    v_fma_f32 v31, v46, v47, v31
    v_max_f32 v58, 0x0da24260, v31
    v_rcp_f32 v58, v58
    s_waitcnt lgkmcnt(0)
    v_add_f32 v192, v192, v194
    v_add_f32 v193, v193, v195
    v_add_f32 v196, v196, v198
    v_add_f32 v197, v197, v199
    v_add_f32 v200, v200, v202
    v_add_f32 v201, v201, v203
    v_add_f32 v204, v204, v206
    v_add_f32 v205, v205, v207
    v_mul_f32 v28, v60, v192
    v_mul_f32 v29, v60, v193
    v_fma_f32 v28, v62, v196, v28
    v_fma_f32 v29, v62, v197, v29
    v_fma_f32 v28, v44, v200, v28
    v_fma_f32 v29, v44, v201, v29
    v_fma_f32 v28, v46, v204, v28
    v_fma_f32 v29, v46, v205, v29
    v_mul_f32 v28, v28, v58
    v_mul_f32 v29, v29, v58
    v_cvt_pk_bf16_f32 v28, v28, v29
    s_nop 0
    ds_swizzle_b32 v12, v28 offset:24
    ds_swizzle_b32 v13, v28 offset:56
    ds_swizzle_b32 v14, v28 offset:88
    ds_swizzle_b32 v15, v28 offset:120
    ds_swizzle_b32 v40, v28 offset:152
    ds_swizzle_b32 v41, v28 offset:184
    ds_swizzle_b32 v42, v28 offset:216
    ds_swizzle_b32 v43, v28 offset:248
    s_mul_i32 s13, s5, 96
    s_add_u32 s13, s13, s4
    s_add_u32 s13, s13, 64
    s_lshl_b32 s13, s13, 11
    s_lshl_b32 s12, s3, 9
    s_add_u32 s13, s13, s12
    s_waitcnt vmcnt(0)
    s_waitcnt lgkmcnt(7)
    v_perm_b32 v44, v12, v12, v4
    v_perm_b32 v45, v12, v12, v5
    v_perm_b32 v46, v12, v12, v6
    v_perm_b32 v47, v12, v12, v7
    v_perm_b32 v48, v12, v12, v8
    v_perm_b32 v49, v12, v12, v9
    v_perm_b32 v50, v12, v12, v10
    v_perm_b32 v51, v12, v12, v11
    v_mfma_f32_16x16x32_bf16 v[32:35], v[44:47], v[64:67], 0
    v_mfma_f32_16x16x32_bf16 v[36:39], v[44:47], v[68:71], 0
    s_waitcnt lgkmcnt(6)
    v_perm_b32 v44, v13, v13, v4
    v_perm_b32 v45, v13, v13, v5
    v_perm_b32 v46, v13, v13, v6
    v_perm_b32 v47, v13, v13, v7
    v_mfma_f32_16x16x32_bf16 v[32:35], v[48:51], v[72:75], v[32:35]
    v_mfma_f32_16x16x32_bf16 v[36:39], v[48:51], v[76:79], v[36:39]
    v_perm_b32 v48, v13, v13, v8
    v_perm_b32 v49, v13, v13, v9
    v_perm_b32 v50, v13, v13, v10
    v_perm_b32 v51, v13, v13, v11
    v_mfma_f32_16x16x32_bf16 v[32:35], v[44:47], v[80:83], v[32:35]
    v_mfma_f32_16x16x32_bf16 v[36:39], v[44:47], v[84:87], v[36:39]
    s_waitcnt lgkmcnt(5)
    v_perm_b32 v44, v14, v14, v4
    v_perm_b32 v45, v14, v14, v5
    v_perm_b32 v46, v14, v14, v6
    v_perm_b32 v47, v14, v14, v7
    v_mfma_f32_16x16x32_bf16 v[32:35], v[48:51], v[88:91], v[32:35]
    v_mfma_f32_16x16x32_bf16 v[36:39], v[48:51], v[92:95], v[36:39]
    v_perm_b32 v48, v14, v14, v8
    v_perm_b32 v49, v14, v14, v9
    v_perm_b32 v50, v14, v14, v10
    v_perm_b32 v51, v14, v14, v11
    v_mfma_f32_16x16x32_bf16 v[32:35], v[44:47], v[96:99], v[32:35]
    v_mfma_f32_16x16x32_bf16 v[36:39], v[44:47], v[100:103], v[36:39]
    s_waitcnt lgkmcnt(4)
    v_perm_b32 v44, v15, v15, v4
    v_perm_b32 v45, v15, v15, v5
    v_perm_b32 v46, v15, v15, v6
    v_perm_b32 v47, v15, v15, v7
    v_mfma_f32_16x16x32_bf16 v[32:35], v[48:51], v[104:107], v[32:35]
    v_mfma_f32_16x16x32_bf16 v[36:39], v[48:51], v[108:111], v[36:39]
    v_perm_b32 v48, v15, v15, v8
    v_perm_b32 v49, v15, v15, v9
    v_perm_b32 v50, v15, v15, v10
    v_perm_b32 v51, v15, v15, v11
    v_mfma_f32_16x16x32_bf16 v[32:35], v[44:47], v[112:115], v[32:35]
    v_mfma_f32_16x16x32_bf16 v[36:39], v[44:47], v[116:119], v[36:39]
    s_waitcnt lgkmcnt(3)
    v_perm_b32 v44, v40, v40, v4
    v_perm_b32 v45, v40, v40, v5
    v_perm_b32 v46, v40, v40, v6
    v_perm_b32 v47, v40, v40, v7
    v_mfma_f32_16x16x32_bf16 v[32:35], v[48:51], v[120:123], v[32:35]
    v_mfma_f32_16x16x32_bf16 v[36:39], v[48:51], v[124:127], v[36:39]
    v_perm_b32 v48, v40, v40, v8
    v_perm_b32 v49, v40, v40, v9
    v_perm_b32 v50, v40, v40, v10
    v_perm_b32 v51, v40, v40, v11
    v_mfma_f32_16x16x32_bf16 v[32:35], v[44:47], v[128:131], v[32:35]
    v_mfma_f32_16x16x32_bf16 v[36:39], v[44:47], v[132:135], v[36:39]
    s_waitcnt lgkmcnt(2)
    v_perm_b32 v44, v41, v41, v4
    v_perm_b32 v45, v41, v41, v5
    v_perm_b32 v46, v41, v41, v6
    v_perm_b32 v47, v41, v41, v7
    v_mfma_f32_16x16x32_bf16 v[32:35], v[48:51], v[136:139], v[32:35]
    v_mfma_f32_16x16x32_bf16 v[36:39], v[48:51], v[140:143], v[36:39]
    v_perm_b32 v48, v41, v41, v8
    v_perm_b32 v49, v41, v41, v9
    v_perm_b32 v50, v41, v41, v10
    v_perm_b32 v51, v41, v41, v11
    v_mfma_f32_16x16x32_bf16 v[32:35], v[44:47], v[144:147], v[32:35]
    v_mfma_f32_16x16x32_bf16 v[36:39], v[44:47], v[148:151], v[36:39]
    s_waitcnt lgkmcnt(1)
    v_perm_b32 v44, v42, v42, v4
    v_perm_b32 v45, v42, v42, v5
    v_perm_b32 v46, v42, v42, v6
    v_perm_b32 v47, v42, v42, v7
    v_mfma_f32_16x16x32_bf16 v[32:35], v[48:51], v[152:155], v[32:35]
    v_mfma_f32_16x16x32_bf16 v[36:39], v[48:51], v[156:159], v[36:39]
    v_perm_b32 v48, v42, v42, v8
    v_perm_b32 v49, v42, v42, v9
    v_perm_b32 v50, v42, v42, v10
    v_perm_b32 v51, v42, v42, v11
    v_mfma_f32_16x16x32_bf16 v[32:35], v[44:47], v[160:163], v[32:35]
    v_mfma_f32_16x16x32_bf16 v[36:39], v[44:47], v[164:167], v[36:39]
    s_waitcnt lgkmcnt(0)
    v_perm_b32 v44, v43, v43, v4
    v_perm_b32 v45, v43, v43, v5
    v_perm_b32 v46, v43, v43, v6
    v_perm_b32 v47, v43, v43, v7
    v_mfma_f32_16x16x32_bf16 v[32:35], v[48:51], v[168:171], v[32:35]
    v_mfma_f32_16x16x32_bf16 v[36:39], v[48:51], v[172:175], v[36:39]
    v_perm_b32 v48, v43, v43, v8
    v_perm_b32 v49, v43, v43, v9
    v_perm_b32 v50, v43, v43, v10
    v_perm_b32 v51, v43, v43, v11
    v_mfma_f32_16x16x32_bf16 v[32:35], v[44:47], v[176:179], v[32:35]
    v_mfma_f32_16x16x32_bf16 v[36:39], v[44:47], v[180:183], v[36:39]
    s_nop 1
    v_mfma_f32_16x16x32_bf16 v[32:35], v[48:51], v[184:187], v[32:35]
    v_mfma_f32_16x16x32_bf16 v[36:39], v[48:51], v[188:191], v[36:39]
    s_nop 7
    ds_bpermute_b32 v192, v18, v32
    ds_bpermute_b32 v193, v18, v33
    ds_bpermute_b32 v194, v18, v34
    ds_bpermute_b32 v195, v18, v35
    ds_bpermute_b32 v196, v18, v36
    ds_bpermute_b32 v197, v18, v37
    ds_bpermute_b32 v198, v18, v38
    ds_bpermute_b32 v199, v18, v39
    s_mov_b32 exec_lo, 0x00ff00ff
    s_mov_b32 exec_hi, 0
    s_waitcnt lgkmcnt(4)
    v_add_f32 v32, v32, v192
    v_add_f32 v33, v33, v193
    v_add_f32 v34, v34, v194
    v_add_f32 v35, v35, v195
    buffer_store_dwordx4 v[32:35], v19, s[84:87], s13 offen sc1
    s_waitcnt lgkmcnt(0)
    v_add_f32 v36, v36, v196
    v_add_f32 v37, v37, v197
    v_add_f32 v38, v38, v198
    v_add_f32 v39, v39, v199
    buffer_store_dwordx4 v[36:39], v19, s[84:87], s13 offen offset:256 sc1
    s_mov_b64 exec, -1
L_pj_a:
    s_add_u32 s11, s25, 0
    buffer_load_dwordx4 v[64:67], v55, s[64:67], s11 offen offset:0
    buffer_load_dwordx4 v[68:71], v55, s[64:67], s11 offen offset:128
    buffer_load_dwordx4 v[72:75], v55, s[64:67], s11 offen offset:1024
    buffer_load_dwordx4 v[76:79], v55, s[64:67], s11 offen offset:1152
    buffer_load_dwordx4 v[80:83], v55, s[64:67], s11 offen offset:2048
    buffer_load_dwordx4 v[84:87], v55, s[64:67], s11 offen offset:2176
    buffer_load_dwordx4 v[88:91], v55, s[64:67], s11 offen offset:3072
    buffer_load_dwordx4 v[92:95], v55, s[64:67], s11 offen offset:3200
    s_add_u32 s11, s25, 4096
    buffer_load_dwordx4 v[96:99], v55, s[64:67], s11 offen offset:0
    buffer_load_dwordx4 v[100:103], v55, s[64:67], s11 offen offset:128
    buffer_load_dwordx4 v[104:107], v55, s[64:67], s11 offen offset:1024
    buffer_load_dwordx4 v[108:111], v55, s[64:67], s11 offen offset:1152
    buffer_load_dwordx4 v[112:115], v55, s[64:67], s11 offen offset:2048
    buffer_load_dwordx4 v[116:119], v55, s[64:67], s11 offen offset:2176
    buffer_load_dwordx4 v[120:123], v55, s[64:67], s11 offen offset:3072
    buffer_load_dwordx4 v[124:127], v55, s[64:67], s11 offen offset:3200
    s_add_u32 s11, s25, 8192
    buffer_load_dwordx4 v[128:131], v55, s[64:67], s11 offen offset:0
    buffer_load_dwordx4 v[132:135], v55, s[64:67], s11 offen offset:128
    buffer_load_dwordx4 v[136:139], v55, s[64:67], s11 offen offset:1024
    buffer_load_dwordx4 v[140:143], v55, s[64:67], s11 offen offset:1152
    buffer_load_dwordx4 v[144:147], v55, s[64:67], s11 offen offset:2048
    buffer_load_dwordx4 v[148:151], v55, s[64:67], s11 offen offset:2176
    buffer_load_dwordx4 v[152:155], v55, s[64:67], s11 offen offset:3072
    buffer_load_dwordx4 v[156:159], v55, s[64:67], s11 offen offset:3200
    s_add_u32 s11, s25, 12288
    buffer_load_dwordx4 v[160:163], v55, s[64:67], s11 offen offset:0
    buffer_load_dwordx4 v[164:167], v55, s[64:67], s11 offen offset:128
    buffer_load_dwordx4 v[168:171], v55, s[64:67], s11 offen offset:1024
    buffer_load_dwordx4 v[172:175], v55, s[64:67], s11 offen offset:1152
    buffer_load_dwordx4 v[176:179], v55, s[64:67], s11 offen offset:2048
    buffer_load_dwordx4 v[180:183], v55, s[64:67], s11 offen offset:2176
    buffer_load_dwordx4 v[184:187], v55, s[64:67], s11 offen offset:3072
    buffer_load_dwordx4 v[188:191], v55, s[64:67], s11 offen offset:3200
    s_waitcnt vmcnt(0) lgkmcnt(0)
    s_barrier
    v_mov_b32 v30, 0
    ds_read_b128 v[60:63], v30 offset:8704
    ds_read_b128 v[44:47], v30 offset:8720
    ds_read_b64 v[192:193], v17 offset:0
    ds_read_b64 v[194:195], v17 offset:512
    ds_read_b64 v[196:197], v17 offset:1024
    ds_read_b64 v[198:199], v17 offset:1536
    ds_read_b64 v[200:201], v17 offset:2048
    ds_read_b64 v[202:203], v17 offset:2560
    ds_read_b64 v[204:205], v17 offset:3072
    ds_read_b64 v[206:207], v17 offset:3584
    s_waitcnt lgkmcnt(8)
    v_max3_f32 v30, v60, v62, v44
    v_max_f32 v30, v46, v30
    v_max_f32 v30, 0xf149f2ca, v30
    v_mul_f32 v57, 0xbfb8aa3b, v30
    v_fma_f32 v60, v60, s14, v57
    v_fma_f32 v62, v62, s14, v57
    v_fma_f32 v44, v44, s14, v57
    v_fma_f32 v46, v46, s14, v57
    v_exp_f32 v60, v60
    v_exp_f32 v62, v62
    v_exp_f32 v44, v44
    v_exp_f32 v46, v46
    s_nop 0
    v_mul_f32 v31, v60, v61
    v_fma_f32 v31, v62, v63, v31
    v_fma_f32 v31, v44, v45, v31
    v_fma_f32 v31, v46, v47, v31
    s_cmp_lg_u32 s3, 0
    s_cbranch_scc1 L_nopub
    v_mov_b32 v28, 0
    s_mov_b64 exec, 1
    buffer_store_dwordx2 v[30:31], v28, s[84:87], s8 offen sc1
    s_mov_b64 exec, -1
L_nopub:
    v_max_f32 v58, 0x0da24260, v31
    v_rcp_f32 v58, v58
    s_waitcnt lgkmcnt(0)
    v_add_f32 v192, v192, v194
    v_add_f32 v193, v193, v195
    v_add_f32 v196, v196, v198
    v_add_f32 v197, v197, v199
    v_add_f32 v200, v200, v202
    v_add_f32 v201, v201, v203
    v_add_f32 v204, v204, v206
    v_add_f32 v205, v205, v207
    v_mul_f32 v28, v60, v192
    v_mul_f32 v29, v60, v193
    v_fma_f32 v28, v62, v196, v28
    v_fma_f32 v29, v62, v197, v29
    v_fma_f32 v28, v44, v200, v28
    v_fma_f32 v29, v44, v201, v29
    v_fma_f32 v28, v46, v204, v28
    v_fma_f32 v29, v46, v205, v29
    v_mul_f32 v28, v28, v58
    v_mul_f32 v29, v29, v58
    v_cvt_pk_bf16_f32 v28, v28, v29
    s_nop 0
    ds_swizzle_b32 v12, v28 offset:24
    ds_swizzle_b32 v13, v28 offset:56
    ds_swizzle_b32 v14, v28 offset:88
    ds_swizzle_b32 v15, v28 offset:120
    ds_swizzle_b32 v40, v28 offset:152
    ds_swizzle_b32 v41, v28 offset:184
    ds_swizzle_b32 v42, v28 offset:216
    ds_swizzle_b32 v43, v28 offset:248
    s_waitcnt lgkmcnt(7)
    v_perm_b32 v44, v12, v12, v4
    v_perm_b32 v45, v12, v12, v5
    v_perm_b32 v46, v12, v12, v6
    v_perm_b32 v47, v12, v12, v7
    v_perm_b32 v48, v12, v12, v8
    v_perm_b32 v49, v12, v12, v9
    v_perm_b32 v50, v12, v12, v10
    v_perm_b32 v51, v12, v12, v11
    v_mfma_f32_16x16x32_bf16 v[32:35], v[44:47], v[64:67], 0
    v_mfma_f32_16x16x32_bf16 v[36:39], v[44:47], v[68:71], 0
    s_waitcnt lgkmcnt(6)
    v_perm_b32 v44, v13, v13, v4
    v_perm_b32 v45, v13, v13, v5
    v_perm_b32 v46, v13, v13, v6
    v_perm_b32 v47, v13, v13, v7
    v_mfma_f32_16x16x32_bf16 v[32:35], v[48:51], v[72:75], v[32:35]
    v_mfma_f32_16x16x32_bf16 v[36:39], v[48:51], v[76:79], v[36:39]
    v_perm_b32 v48, v13, v13, v8
    v_perm_b32 v49, v13, v13, v9
    v_perm_b32 v50, v13, v13, v10
    v_perm_b32 v51, v13, v13, v11
    v_mfma_f32_16x16x32_bf16 v[32:35], v[44:47], v[80:83], v[32:35]
    v_mfma_f32_16x16x32_bf16 v[36:39], v[44:47], v[84:87], v[36:39]
    s_waitcnt lgkmcnt(5)
    v_perm_b32 v44, v14, v14, v4
    v_perm_b32 v45, v14, v14, v5
    v_perm_b32 v46, v14, v14, v6
    v_perm_b32 v47, v14, v14, v7
    v_mfma_f32_16x16x32_bf16 v[32:35], v[48:51], v[88:91], v[32:35]
    v_mfma_f32_16x16x32_bf16 v[36:39], v[48:51], v[92:95], v[36:39]
    v_perm_b32 v48, v14, v14, v8
    v_perm_b32 v49, v14, v14, v9
    v_perm_b32 v50, v14, v14, v10
    v_perm_b32 v51, v14, v14, v11
    v_mfma_f32_16x16x32_bf16 v[32:35], v[44:47], v[96:99], v[32:35]
    v_mfma_f32_16x16x32_bf16 v[36:39], v[44:47], v[100:103], v[36:39]
    s_waitcnt lgkmcnt(4)
    v_perm_b32 v44, v15, v15, v4
    v_perm_b32 v45, v15, v15, v5
    v_perm_b32 v46, v15, v15, v6
    v_perm_b32 v47, v15, v15, v7
    v_mfma_f32_16x16x32_bf16 v[32:35], v[48:51], v[104:107], v[32:35]
    v_mfma_f32_16x16x32_bf16 v[36:39], v[48:51], v[108:111], v[36:39]
    v_perm_b32 v48, v15, v15, v8
    v_perm_b32 v49, v15, v15, v9
    v_perm_b32 v50, v15, v15, v10
    v_perm_b32 v51, v15, v15, v11
    v_mfma_f32_16x16x32_bf16 v[32:35], v[44:47], v[112:115], v[32:35]
    v_mfma_f32_16x16x32_bf16 v[36:39], v[44:47], v[116:119], v[36:39]
    s_waitcnt lgkmcnt(3)
    v_perm_b32 v44, v40, v40, v4
    v_perm_b32 v45, v40, v40, v5
    v_perm_b32 v46, v40, v40, v6
    v_perm_b32 v47, v40, v40, v7
    v_mfma_f32_16x16x32_bf16 v[32:35], v[48:51], v[120:123], v[32:35]
    v_mfma_f32_16x16x32_bf16 v[36:39], v[48:51], v[124:127], v[36:39]
    v_perm_b32 v48, v40, v40, v8
    v_perm_b32 v49, v40, v40, v9
    v_perm_b32 v50, v40, v40, v10
    v_perm_b32 v51, v40, v40, v11
    v_mfma_f32_16x16x32_bf16 v[32:35], v[44:47], v[128:131], v[32:35]
    v_mfma_f32_16x16x32_bf16 v[36:39], v[44:47], v[132:135], v[36:39]
    s_waitcnt lgkmcnt(2)
    v_perm_b32 v44, v41, v41, v4
    v_perm_b32 v45, v41, v41, v5
    v_perm_b32 v46, v41, v41, v6
    v_perm_b32 v47, v41, v41, v7
    v_mfma_f32_16x16x32_bf16 v[32:35], v[48:51], v[136:139], v[32:35]
    v_mfma_f32_16x16x32_bf16 v[36:39], v[48:51], v[140:143], v[36:39]
    v_perm_b32 v48, v41, v41, v8
    v_perm_b32 v49, v41, v41, v9
    v_perm_b32 v50, v41, v41, v10
    v_perm_b32 v51, v41, v41, v11
    v_mfma_f32_16x16x32_bf16 v[32:35], v[44:47], v[144:147], v[32:35]
    v_mfma_f32_16x16x32_bf16 v[36:39], v[44:47], v[148:151], v[36:39]
    s_waitcnt lgkmcnt(1)
    v_perm_b32 v44, v42, v42, v4
    v_perm_b32 v45, v42, v42, v5
    v_perm_b32 v46, v42, v42, v6
    v_perm_b32 v47, v42, v42, v7
    v_mfma_f32_16x16x32_bf16 v[32:35], v[48:51], v[152:155], v[32:35]
    v_mfma_f32_16x16x32_bf16 v[36:39], v[48:51], v[156:159], v[36:39]
    v_perm_b32 v48, v42, v42, v8
    v_perm_b32 v49, v42, v42, v9
    v_perm_b32 v50, v42, v42, v10
    v_perm_b32 v51, v42, v42, v11
    v_mfma_f32_16x16x32_bf16 v[32:35], v[44:47], v[160:163], v[32:35]
    v_mfma_f32_16x16x32_bf16 v[36:39], v[44:47], v[164:167], v[36:39]
    s_waitcnt lgkmcnt(0)
    v_perm_b32 v44, v43, v43, v4
    v_perm_b32 v45, v43, v43, v5
    v_perm_b32 v46, v43, v43, v6
    v_perm_b32 v47, v43, v43, v7
    v_mfma_f32_16x16x32_bf16 v[32:35], v[48:51], v[168:171], v[32:35]
    v_mfma_f32_16x16x32_bf16 v[36:39], v[48:51], v[172:175], v[36:39]
    v_perm_b32 v48, v43, v43, v8
    v_perm_b32 v49, v43, v43, v9
    v_perm_b32 v50, v43, v43, v10
    v_perm_b32 v51, v43, v43, v11
    v_mfma_f32_16x16x32_bf16 v[32:35], v[44:47], v[176:179], v[32:35]
    v_mfma_f32_16x16x32_bf16 v[36:39], v[44:47], v[180:183], v[36:39]
    s_nop 1
    v_mfma_f32_16x16x32_bf16 v[32:35], v[48:51], v[184:187], v[32:35]
    v_mfma_f32_16x16x32_bf16 v[36:39], v[48:51], v[188:191], v[36:39]
    s_nop 7
    ds_bpermute_b32 v192, v18, v32
    ds_bpermute_b32 v193, v18, v33
    ds_bpermute_b32 v194, v18, v34
    ds_bpermute_b32 v195, v18, v35
    ds_bpermute_b32 v196, v18, v36
    ds_bpermute_b32 v197, v18, v37
    ds_bpermute_b32 v198, v18, v38
    ds_bpermute_b32 v199, v18, v39
    s_mov_b32 exec_lo, 0x00ff00ff
    s_mov_b32 exec_hi, 0
    s_waitcnt lgkmcnt(4)
    v_add_f32 v32, v32, v192
    v_add_f32 v33, v33, v193
    v_add_f32 v34, v34, v194
    v_add_f32 v35, v35, v195
    buffer_store_dwordx4 v[32:35], v19, s[84:87], s9 offen sc1
    s_waitcnt lgkmcnt(0)
    v_add_f32 v36, v36, v196
    v_add_f32 v37, v37, v197
    v_add_f32 v38, v38, v198
    v_add_f32 v39, v39, v199
    buffer_store_dwordx4 v[36:39], v19, s[84:87], s9 offen offset:256 sc1
    s_mov_b64 exec, -1
    s_waitcnt vmcnt(0)
    s_branch L_pub
L_stream:
    v_mov_b32 v32, 0
    v_mov_b32 v33, 0
    v_mov_b32 v34, 0
    v_mov_b32 v35, 0
    v_mov_b32 v36, 0
    v_mov_b32 v37, 0
    v_mov_b32 v38, 0
    v_mov_b32 v39, 0
    v_mov_b32 v40, 0xff800000
    v_mov_b32 v41, 0
    s_xor_b32 s7, s6, 1
    s_lshl_b32 s91, s6, 12
    s_lshl_b32 s92, s6, 5
    s_add_u32 s92, s92, 8704
    s_waitcnt lgkmcnt(0)
    s_cmp_ge_u32 s99, 640
    s_cbranch_scc1 L_done
    s_cmp_lg_u32 s97, 0
    s_cbranch_scc1 L_gpoolpre
    s_mov_b64 exec, 1
    ds_add_rtn_u32 v54, v52, v53
    s_mov_b64 exec, -1
    s_branch L_gdonepre
L_gpoolpre:
    s_mov_b32 s98, 1
    s_atomic_add s98, s[16:17], 0 glc
L_gdonepre:
.p2align 6
L_loop:
    s_cmp_ge_u32 s99, 640
    s_cbranch_scc1 L_done
    s_cmp_lt_u32 s99, 512
    s_cbranch_scc1 L_nosw0
    s_cmp_lg_u32 s7, 0
    s_cbranch_scc1 L_nosw0
    s_nop 7
    v_add_f32_dpp v41, v41, v41 row_ror:8 row_mask:0xf bank_mask:0xf
    s_nop 1
    v_add_f32_dpp v41, v41, v41 row_bcast:15 row_mask:0xa bank_mask:0xf
    s_nop 1
    v_add_f32_dpp v41, v41, v41 row_bcast:31 row_mask:0xc bank_mask:0xf
    v_add_u32 v28, s91, v56
    s_lshl_b32 s11, s24, 3
    s_add_u32 s11, s11, s92
    v_mov_b32 v29, s11
    s_mov_b64 exec, s[88:89]
    ds_write_b128 v28, v[32:35]
    ds_write_b128 v28, v[36:39] offset:256
    s_mov_b32 exec_lo, 0
    s_mov_b32 exec_hi, 0x80000000
    ds_write_b64 v29, v[40:41]
    s_mov_b64 exec, -1
    s_mov_b64 exec, 1
    ds_add_u32 v52, v53 offset:8
    s_mov_b64 exec, -1
    ds_read_b128 v[12:15], v16 offset:8192
    s_nop 1
    v_mov_b32 v32, 0
    v_mov_b32 v33, 0
    v_mov_b32 v34, 0
    v_mov_b32 v35, 0
    v_mov_b32 v36, 0
    v_mov_b32 v37, 0
    v_mov_b32 v38, 0
    v_mov_b32 v39, 0
    v_mov_b32 v40, 0xff800000
    v_mov_b32 v41, 0
    s_mov_b32 s91, 0
    s_mov_b32 s92, 8704
    s_mov_b32 s7, 1
    s_waitcnt lgkmcnt(0)
L_nosw0:
    s_waitcnt lgkmcnt(0)
    s_cmp_lg_u32 s97, 0
    s_cbranch_scc1 L_havps0
    v_readfirstlane_b32 s98, v54
    s_nop 0
    s_cmp_lt_u32 s98, s60
    s_cbranch_scc1 L_havs0
    s_mov_b32 s97, 1
L_fws0:
    ds_read_b32 v54, v52 offset:4
    s_waitcnt lgkmcnt(0)
    v_readfirstlane_b32 s98, v54
    s_nop 0
    s_cmp_eq_u32 s98, 0
    s_cbranch_scc1 L_fws0
    s_mov_b32 s98, 1
    s_atomic_add s98, s[16:17], 0 glc
    s_waitcnt lgkmcnt(0)
L_havps0:
    s_add_u32 s98, s98, 512
L_havs0:
    s_mov_b32 s99, s98
    s_cmp_lt_u32 s99, 512
    s_cselect_b32 s44, s22, s18
    s_cselect_b32 s45, s23, s19
    s_cselect_b32 s48, s26, s20
    s_cselect_b32 s49, s27, s21
    s_cselect_b32 s8, s90, s96
    s_and_b32 s11, s99, 511
    s_lshl_b32 s11, s11, 13
    s_add_u32 s8, s8, s11
    s_add_u32 s9, s8, 4096
    s_cmp_ge_u32 s99, 640
    s_cselect_b32 s46, 0, s46
    s_cselect_b32 s50, 0, s50
    s_cmp_lg_u32 s97, 0
    s_cbranch_scc1 L_gpools0
    s_mov_b64 exec, 1
    ds_add_rtn_u32 v54, v52, v53
    s_mov_b64 exec, -1
    s_branch L_gdones0
L_gpools0:
    s_mov_b32 s98, 1
    s_atomic_add s98, s[16:17], 0 glc
L_gdones0:
    s_waitcnt vmcnt(14)
    v_dot2_f32_bf16 v20, v128, v12, 0
    v_dot2_f32_bf16 v21, v132, v12, 0
    v_dot2_f32_bf16 v20, v129, v13, v20
    v_dot2_f32_bf16 v21, v133, v13, v21
    v_dot2_f32_bf16 v20, v130, v14, v20
    v_dot2_f32_bf16 v21, v134, v14, v21
    v_dot2_f32_bf16 v20, v131, v15, v20
    v_dot2_f32_bf16 v21, v135, v15, v21
    buffer_load_dwordx4 v[128:131], v2, s[44:47], s8 offen offset:0 nt
    buffer_load_dwordx4 v[132:135], v2, s[44:47], s8 offen offset:1024 nt
    s_waitcnt vmcnt(14)
    v_dot2_f32_bf16 v22, v136, v12, 0
    v_dot2_f32_bf16 v23, v140, v12, 0
    v_dot2_f32_bf16 v22, v137, v13, v22
    v_dot2_f32_bf16 v23, v141, v13, v23
    v_dot2_f32_bf16 v22, v138, v14, v22
    v_dot2_f32_bf16 v23, v142, v14, v23
    v_dot2_f32_bf16 v22, v139, v15, v22
    v_dot2_f32_bf16 v23, v143, v15, v23
    buffer_load_dwordx4 v[136:139], v2, s[44:47], s8 offen offset:2048 nt
    buffer_load_dwordx4 v[140:143], v2, s[44:47], s8 offen offset:3072 nt
    s_waitcnt vmcnt(14)
    v_dot2_f32_bf16 v24, v144, v12, 0
    v_dot2_f32_bf16 v25, v148, v12, 0
    v_dot2_f32_bf16 v24, v145, v13, v24
    v_dot2_f32_bf16 v25, v149, v13, v25
    v_dot2_f32_bf16 v24, v146, v14, v24
    v_dot2_f32_bf16 v25, v150, v14, v25
    v_dot2_f32_bf16 v24, v147, v15, v24
    v_dot2_f32_bf16 v25, v151, v15, v25
    buffer_load_dwordx4 v[144:147], v2, s[44:47], s9 offen offset:0 nt
    buffer_load_dwordx4 v[148:151], v2, s[44:47], s9 offen offset:1024 nt
    s_waitcnt vmcnt(14)
    v_dot2_f32_bf16 v26, v152, v12, 0
    v_dot2_f32_bf16 v27, v156, v12, 0
    v_dot2_f32_bf16 v26, v153, v13, v26
    v_dot2_f32_bf16 v27, v157, v13, v27
    v_dot2_f32_bf16 v26, v154, v14, v26
    v_dot2_f32_bf16 v27, v158, v14, v27
    v_dot2_f32_bf16 v26, v155, v15, v26
    v_dot2_f32_bf16 v27, v159, v15, v27
    buffer_load_dwordx4 v[152:155], v2, s[44:47], s9 offen offset:2048 nt
    buffer_load_dwordx4 v[156:159], v2, s[44:47], s9 offen offset:3072 nt
    s_nop 0
    v_add_f32_dpp v20, v20, v20 row_ror:8 row_mask:0xf bank_mask:0x3
    v_add_f32_dpp v22, v22, v22 row_ror:8 row_mask:0xf bank_mask:0x3
    v_add_f32_dpp v24, v24, v24 row_ror:8 row_mask:0xf bank_mask:0x3
    v_add_f32_dpp v26, v26, v26 row_ror:8 row_mask:0xf bank_mask:0x3
    v_add_f32_dpp v20, v21, v21 row_ror:8 row_mask:0xf bank_mask:0xc
    v_add_f32_dpp v22, v23, v23 row_ror:8 row_mask:0xf bank_mask:0xc
    v_add_f32_dpp v24, v25, v25 row_ror:8 row_mask:0xf bank_mask:0xc
    v_add_f32_dpp v26, v27, v27 row_ror:8 row_mask:0xf bank_mask:0xc
    v_add_f32_dpp v20, v20, v20 row_half_mirror row_mask:0xf bank_mask:0xf
    v_add_f32_dpp v22, v22, v22 row_half_mirror row_mask:0xf bank_mask:0xf
    v_add_f32_dpp v24, v24, v24 row_half_mirror row_mask:0xf bank_mask:0xf
    v_add_f32_dpp v26, v26, v26 row_half_mirror row_mask:0xf bank_mask:0xf
    v_add_f32_dpp v20, v20, v20 quad_perm:[1,0,3,2] row_mask:0xf bank_mask:0xf
    v_add_f32_dpp v22, v22, v22 quad_perm:[1,0,3,2] row_mask:0xf bank_mask:0xf
    v_add_f32_dpp v24, v24, v24 quad_perm:[1,0,3,2] row_mask:0xf bank_mask:0xf
    v_add_f32_dpp v26, v26, v26 quad_perm:[1,0,3,2] row_mask:0xf bank_mask:0xf
    v_add_f32_dpp v20, v20, v20 quad_perm:[2,3,0,1] row_mask:0xf bank_mask:0xf
    v_add_f32_dpp v22, v22, v22 quad_perm:[2,3,0,1] row_mask:0xf bank_mask:0xf
    v_add_f32_dpp v24, v24, v24 quad_perm:[2,3,0,1] row_mask:0xf bank_mask:0xf
    v_add_f32_dpp v26, v26, v26 quad_perm:[2,3,0,1] row_mask:0xf bank_mask:0xf
    v_cvt_pk_bf16_f32 v28, v20, v22
    v_cvt_pk_bf16_f32 v29, v24, v26
    v_lshlrev_b32 v20, 16, v28
    v_and_b32 v22, 0xffff0000, v28
    v_lshlrev_b32 v24, 16, v29
    v_and_b32 v26, 0xffff0000, v29
    v_mul_f32 v20, s15, v20
    v_mul_f32 v22, s15, v22
    v_mul_f32 v24, s15, v24
    v_mul_f32 v26, s15, v26
    v_cvt_pk_bf16_f32 v28, v20, v22
    v_cvt_pk_bf16_f32 v29, v24, v26
    v_lshlrev_b32 v20, 16, v28
    v_and_b32 v22, 0xffff0000, v28
    v_lshlrev_b32 v24, 16, v29
    v_and_b32 v26, 0xffff0000, v29
    v_max3_f32 v30, v20, v22, v40
    v_max3_f32 v30, v24, v26, v30
    s_nop 1
    v_max_f32_dpp v30, v30, v30 row_ror:8 row_mask:0xf bank_mask:0xf
    s_nop 1
    v_max_f32_dpp v30, v30, v30 row_bcast:15 row_mask:0xa bank_mask:0xf
    s_nop 1
    v_max_f32_dpp v30, v30, v30 row_bcast:31 row_mask:0xc bank_mask:0xf
    s_nop 0
    v_readlane_b32 s10, v30, 63
    s_nop 1
    v_mov_b32 v59, s10
    v_mul_f32 v57, 0xbfb8aa3b, v59
    v_fma_f32 v58, v40, s14, v57
    v_fma_f32 v20, v20, s14, v57
    v_fma_f32 v22, v22, s14, v57
    v_fma_f32 v24, v24, s14, v57
    v_fma_f32 v26, v26, s14, v57
    v_exp_f32 v58, v58
    v_exp_f32 v20, v20
    v_exp_f32 v22, v22
    v_exp_f32 v24, v24
    v_exp_f32 v26, v26
    v_mov_b32 v40, v59
    v_mul_f32 v32, v58, v32
    v_mul_f32 v33, v58, v33
    v_mul_f32 v34, v58, v34
    v_mul_f32 v35, v58, v35
    v_mul_f32 v36, v58, v36
    v_mul_f32 v37, v58, v37
    v_mul_f32 v38, v58, v38
    v_mul_f32 v39, v58, v39
    v_cvt_pk_bf16_f32 v42, v20, v22
    v_cvt_pk_bf16_f32 v43, v24, v26
    v_add_f32 v28, v20, v22
    v_add_f32 v29, v24, v26
    v_perm_b32 v44, v42, v42, v4
    v_perm_b32 v45, v42, v42, v5
    v_perm_b32 v46, v42, v42, v6
    v_perm_b32 v47, v42, v42, v7
    v_add_f32 v28, v28, v29
    v_perm_b32 v48, v42, v42, v8
    v_perm_b32 v49, v42, v42, v9
    v_perm_b32 v50, v42, v42, v10
    v_perm_b32 v51, v42, v42, v11
    v_fma_f32 v41, v41, v58, v28
    s_waitcnt vmcnt(14)
    v_mfma_f32_16x16x32_bf16 v[32:35], v[44:47], v[160:163], v[32:35]
    v_mfma_f32_16x16x32_bf16 v[36:39], v[44:47], v[164:167], v[36:39]
    buffer_load_dwordx4 v[160:163], v3, s[48:51], s8 offen offset:0 nt
    buffer_load_dwordx4 v[164:167], v3, s[48:51], s8 offen offset:128 nt
    v_perm_b32 v44, v43, v43, v4
    v_perm_b32 v45, v43, v43, v5
    v_perm_b32 v46, v43, v43, v6
    v_perm_b32 v47, v43, v43, v7
    s_waitcnt vmcnt(14)
    v_mfma_f32_16x16x32_bf16 v[32:35], v[48:51], v[168:171], v[32:35]
    v_mfma_f32_16x16x32_bf16 v[36:39], v[48:51], v[172:175], v[36:39]
    buffer_load_dwordx4 v[168:171], v3, s[48:51], s8 offen offset:2048 nt
    buffer_load_dwordx4 v[172:175], v3, s[48:51], s8 offen offset:2176 nt
    v_perm_b32 v48, v43, v43, v8
    v_perm_b32 v49, v43, v43, v9
    v_perm_b32 v50, v43, v43, v10
    v_perm_b32 v51, v43, v43, v11
    s_waitcnt vmcnt(14)
    v_mfma_f32_16x16x32_bf16 v[32:35], v[44:47], v[176:179], v[32:35]
    v_mfma_f32_16x16x32_bf16 v[36:39], v[44:47], v[180:183], v[36:39]
    buffer_load_dwordx4 v[176:179], v3, s[48:51], s9 offen offset:0 nt
    buffer_load_dwordx4 v[180:183], v3, s[48:51], s9 offen offset:128 nt
    s_waitcnt vmcnt(14)
    v_mfma_f32_16x16x32_bf16 v[32:35], v[48:51], v[184:187], v[32:35]
    v_mfma_f32_16x16x32_bf16 v[36:39], v[48:51], v[188:191], v[36:39]
    buffer_load_dwordx4 v[184:187], v3, s[48:51], s9 offen offset:2048 nt
    buffer_load_dwordx4 v[188:191], v3, s[48:51], s9 offen offset:2176 nt
    s_branch L_loop
L_done:
    s_waitcnt lgkmcnt(0)
    s_cmp_lg_u32 s7, 0
    s_cbranch_scc1 L_fin_save
    s_nop 7
    v_add_f32_dpp v41, v41, v41 row_ror:8 row_mask:0xf bank_mask:0xf
    s_nop 1
    v_add_f32_dpp v41, v41, v41 row_bcast:15 row_mask:0xa bank_mask:0xf
    s_nop 1
    v_add_f32_dpp v41, v41, v41 row_bcast:31 row_mask:0xc bank_mask:0xf
    v_add_u32 v28, s91, v56
    s_lshl_b32 s11, s24, 3
    s_add_u32 s11, s11, s92
    v_mov_b32 v29, s11
    s_mov_b64 exec, s[88:89]
    ds_write_b128 v28, v[32:35]
    ds_write_b128 v28, v[36:39] offset:256
    s_mov_b32 exec_lo, 0
    s_mov_b32 exec_hi, 0x80000000
    ds_write_b64 v29, v[40:41]
    s_mov_b64 exec, -1
    s_mov_b64 exec, 1
    ds_add_u32 v52, v53 offset:8
    s_mov_b64 exec, -1
    s_nop 1
    v_mov_b32 v32, 0
    v_mov_b32 v33, 0
    v_mov_b32 v34, 0
    v_mov_b32 v35, 0
    v_mov_b32 v36, 0
    v_mov_b32 v37, 0
    v_mov_b32 v38, 0
    v_mov_b32 v39, 0
    v_mov_b32 v40, 0xff800000
    v_mov_b32 v41, 0
    s_mov_b32 s91, 0
    s_mov_b32 s92, 8704
    s_mov_b32 s7, 1
    s_waitcnt lgkmcnt(0)
L_fin_save:
    s_nop 7
    v_add_f32_dpp v41, v41, v41 row_ror:8 row_mask:0xf bank_mask:0xf
    s_nop 1
    v_add_f32_dpp v41, v41, v41 row_bcast:15 row_mask:0xa bank_mask:0xf
    s_nop 1
    v_add_f32_dpp v41, v41, v41 row_bcast:31 row_mask:0xc bank_mask:0xf
    v_add_u32 v28, s91, v56
    s_lshl_b32 s11, s24, 3
    s_add_u32 s11, s11, s92
    v_mov_b32 v29, s11
    s_mov_b64 exec, s[88:89]
    ds_write_b128 v28, v[32:35]
    ds_write_b128 v28, v[36:39] offset:256
    s_mov_b32 exec_lo, 0
    s_mov_b32 exec_hi, 0x80000000
    ds_write_b64 v29, v[40:41]
    s_mov_b64 exec, -1
    s_waitcnt lgkmcnt(0)
    s_barrier
    s_waitcnt vmcnt(0)
L_pub:
    s_barrier
    s_mov_b32 s95, 0
    s_cmp_lg_u32 s6, 0
    s_cbranch_scc1 L_fin
    s_cmp_lg_u32 s3, 0
    s_cbranch_scc1 L_wait_idx
    s_lshl_b32 s11, s5, 5
    v_mov_b32 v28, s11
    v_mov_b32 v29, 1
    s_mov_b64 exec, 1
    buffer_atomic_add v29, v28, s[80:83], 0 offen sc0
    s_waitcnt vmcnt(0)
    v_readfirstlane_b32 s12, v29
    s_sub_u32 s12, s12, 18
    s_cmp_ge_u32 s12, 8
    s_cbranch_scc1 L_idx_pub
L_poll:
    s_mov_b64 s[28:29], 0
    s_atomic_or_x2 s[28:29], s[32:33], 0 glc
    s_waitcnt lgkmcnt(0)
    s_add_u32 s95, s95, 1
    s_and_b32 s28, s28, s29
    s_cmp_eq_u32 s28, -1
    s_cbranch_scc1 L_init_ok
    s_sleep 16
    s_cmp_lt_u32 s95, 100000
    s_cbranch_scc1 L_poll
L_init_ok:
    s_mov_b32 exec_lo, -1
    s_mov_b32 exec_hi, 0
    s_lshl_b32 s13, s5, 9
    s_add_u32 s13, s13, 786432
    s_mov_b32 s95, 0
L_mlp:
    buffer_load_dwordx4 v[128:131], v2, s[84:87], s13 offen sc1
    s_waitcnt vmcnt(0)
    v_max3_u32 v30, v128, v129, v130
    v_max_u32 v30, v131, v30
    v_cmp_eq_u32 vcc, -1, v30
    s_add_u32 s95, s95, 1
    s_nop 0
    s_and_b64 exec, exec, vcc
    s_cbranch_execz L_mld
    s_cmp_ge_u32 s95, 200000
    s_cbranch_scc1 L_mld
    s_sleep 4
    s_branch L_mlp
L_mld:
    s_mov_b64 exec, 1
L_idx_pub:
    v_mov_b32 v30, 8780
    ds_write_b32 v30, v29
    s_mov_b64 exec, -1
    s_waitcnt lgkmcnt(0)
L_wait_idx:
    s_barrier
    v_mov_b32 v30, 8780
    ds_read_b32 v29, v30
    v_and_b32 v30, 31, v1
    v_lshrrev_b32 v31, 5, v1
    v_lshlrev_b32 v60, 11, v30
    v_lshl_add_u32 v60, v31, 4, v60
    v_lshlrev_b32 v61, 4, v30
    s_waitcnt lgkmcnt(0)
    v_readfirstlane_b32 s12, v29
    s_sub_u32 s12, s12, 18
    s_cmp_ge_u32 s12, 8
    s_cbranch_scc1 L_fin
    s_lshl_b32 s12, s12, 3
    s_add_u32 s12, s12, s3
    s_mul_i32 s11, s5, 196608
    s_lshl_b32 s13, s12, 5
    s_add_u32 s11, s11, s13
    s_add_u32 s8, s11, 65536
    s_add_u32 s9, s11, 131072
    s_lshl_b32 s13, s5, 9
    s_add_u32 s13, s13, 786432
    s_mov_b32 s95, 0
L_rpoll:
    buffer_load_dwordx4 v[140:143], v61, s[84:87], s13 offen sc1
    buffer_load_dwordx4 v[128:131], v60, s[84:87], s11 offen sc1
    buffer_load_dwordx4 v[132:135], v60, s[84:87], s8 offen sc1
    buffer_load_dwordx4 v[136:139], v60, s[84:87], s9 offen sc1
    s_waitcnt vmcnt(0)
    v_max3_u32 v28, v128, v129, v130
    v_max3_u32 v29, v131, v132, v133
    v_max3_u32 v30, v134, v135, v136
    v_max3_u32 v28, v137, v138, v28
    v_max3_u32 v29, v139, v140, v29
    v_max3_u32 v30, v141, v142, v30
    v_max3_u32 v28, v143, v29, v28
    v_max_u32 v28, v28, v30
    v_cmp_eq_u32 vcc, -1, v28
    s_add_u32 s95, s95, 1
    s_nop 0
    s_and_b64 exec, exec, vcc
    s_cbranch_execz L_rdone
    s_cmp_ge_u32 s95, 200000
    s_cbranch_scc1 L_rdone
    s_sleep 2
    s_branch L_rpoll
L_rdone:
    s_mov_b64 exec, -1
    v_max_f32 v30, v140, v142
    v_sub_f32 v140, v140, v30
    v_sub_f32 v142, v142, v30
    v_mul_f32 v140, s14, v140
    v_mul_f32 v142, s14, v142
    v_exp_f32 v140, v140
    v_exp_f32 v142, v142
    s_nop 0
    v_mul_f32 v140, v140, v141
    v_mul_f32 v142, v142, v143
    v_add_f32 v30, v140, v142
    v_rcp_f32 v30, v30
    s_nop 0
    v_mul_f32 v140, v140, v30
    v_mul_f32 v142, v142, v30
    v_mul_f32 v128, v140, v128
    v_mul_f32 v129, v140, v129
    v_mul_f32 v130, v140, v130
    v_mul_f32 v131, v140, v131
    v_fma_f32 v132, v142, v132, v128
    v_fma_f32 v133, v142, v133, v129
    v_fma_f32 v134, v142, v134, v130
    v_fma_f32 v135, v142, v135, v131
    v_add_f32_dpp v132, v132, v132 row_ror:8 row_mask:0xf bank_mask:0xf
    v_add_f32_dpp v133, v133, v133 row_ror:8 row_mask:0xf bank_mask:0xf
    v_add_f32_dpp v134, v134, v134 row_ror:8 row_mask:0xf bank_mask:0xf
    v_add_f32_dpp v135, v135, v135 row_ror:8 row_mask:0xf bank_mask:0xf
    v_add_f32_dpp v136, v136, v136 row_ror:8 row_mask:0xf bank_mask:0xf
    v_add_f32_dpp v137, v137, v137 row_ror:8 row_mask:0xf bank_mask:0xf
    v_add_f32_dpp v138, v138, v138 row_ror:8 row_mask:0xf bank_mask:0xf
    v_add_f32_dpp v139, v139, v139 row_ror:8 row_mask:0xf bank_mask:0xf
    v_add_f32_dpp v132, v132, v132 row_ror:4 row_mask:0xf bank_mask:0xf
    v_add_f32_dpp v133, v133, v133 row_ror:4 row_mask:0xf bank_mask:0xf
    v_add_f32_dpp v134, v134, v134 row_ror:4 row_mask:0xf bank_mask:0xf
    v_add_f32_dpp v135, v135, v135 row_ror:4 row_mask:0xf bank_mask:0xf
    v_add_f32_dpp v136, v136, v136 row_ror:4 row_mask:0xf bank_mask:0xf
    v_add_f32_dpp v137, v137, v137 row_ror:4 row_mask:0xf bank_mask:0xf
    v_add_f32_dpp v138, v138, v138 row_ror:4 row_mask:0xf bank_mask:0xf
    v_add_f32_dpp v139, v139, v139 row_ror:4 row_mask:0xf bank_mask:0xf
    v_add_f32_dpp v132, v132, v132 row_ror:2 row_mask:0xf bank_mask:0xf
    v_add_f32_dpp v133, v133, v133 row_ror:2 row_mask:0xf bank_mask:0xf
    v_add_f32_dpp v134, v134, v134 row_ror:2 row_mask:0xf bank_mask:0xf
    v_add_f32_dpp v135, v135, v135 row_ror:2 row_mask:0xf bank_mask:0xf
    v_add_f32_dpp v136, v136, v136 row_ror:2 row_mask:0xf bank_mask:0xf
    v_add_f32_dpp v137, v137, v137 row_ror:2 row_mask:0xf bank_mask:0xf
    v_add_f32_dpp v138, v138, v138 row_ror:2 row_mask:0xf bank_mask:0xf
    v_add_f32_dpp v139, v139, v139 row_ror:2 row_mask:0xf bank_mask:0xf
    v_add_f32_dpp v132, v132, v132 row_ror:1 row_mask:0xf bank_mask:0xf
    v_add_f32_dpp v133, v133, v133 row_ror:1 row_mask:0xf bank_mask:0xf
    v_add_f32_dpp v134, v134, v134 row_ror:1 row_mask:0xf bank_mask:0xf
    v_add_f32_dpp v135, v135, v135 row_ror:1 row_mask:0xf bank_mask:0xf
    v_add_f32_dpp v136, v136, v136 row_ror:1 row_mask:0xf bank_mask:0xf
    v_add_f32_dpp v137, v137, v137 row_ror:1 row_mask:0xf bank_mask:0xf
    v_add_f32_dpp v138, v138, v138 row_ror:1 row_mask:0xf bank_mask:0xf
    v_add_f32_dpp v139, v139, v139 row_ror:1 row_mask:0xf bank_mask:0xf
    v_add_f32_dpp v132, v132, v132 row_bcast:15 row_mask:0xa bank_mask:0xf
    v_add_f32_dpp v133, v133, v133 row_bcast:15 row_mask:0xa bank_mask:0xf
    v_add_f32_dpp v134, v134, v134 row_bcast:15 row_mask:0xa bank_mask:0xf
    v_add_f32_dpp v135, v135, v135 row_bcast:15 row_mask:0xa bank_mask:0xf
    v_add_f32_dpp v136, v136, v136 row_bcast:15 row_mask:0xa bank_mask:0xf
    v_add_f32_dpp v137, v137, v137 row_bcast:15 row_mask:0xa bank_mask:0xf
    v_add_f32_dpp v138, v138, v138 row_bcast:15 row_mask:0xa bank_mask:0xf
    v_add_f32_dpp v139, v139, v139 row_bcast:15 row_mask:0xa bank_mask:0xf
    v_cvt_pk_bf16_f32 v30, v132, v133
    v_lshlrev_b32 v132, 16, v30
    v_and_b32 v133, 0xffff0000, v30
    v_cvt_pk_bf16_f32 v30, v134, v135
    v_lshlrev_b32 v134, 16, v30
    v_and_b32 v135, 0xffff0000, v30
    v_cvt_pk_bf16_f32 v30, v136, v137
    v_lshlrev_b32 v136, 16, v30
    v_and_b32 v137, 0xffff0000, v30
    v_cvt_pk_bf16_f32 v30, v138, v139
    v_lshlrev_b32 v138, 16, v30
    v_and_b32 v139, 0xffff0000, v30
    v_mul_f32 v132, s93, v132
    v_mul_f32 v136, s94, v136
    v_mul_f32 v133, s93, v133
    v_mul_f32 v137, s94, v137
    v_mul_f32 v134, s93, v134
    v_mul_f32 v138, s94, v138
    v_mul_f32 v135, s93, v135
    v_mul_f32 v139, s94, v139
    v_cvt_pk_bf16_f32 v30, v132, v133
    v_lshlrev_b32 v132, 16, v30
    v_and_b32 v133, 0xffff0000, v30
    v_cvt_pk_bf16_f32 v30, v134, v135
    v_lshlrev_b32 v134, 16, v30
    v_and_b32 v135, 0xffff0000, v30
    v_cvt_pk_bf16_f32 v30, v136, v137
    v_lshlrev_b32 v136, 16, v30
    v_and_b32 v137, 0xffff0000, v30
    v_cvt_pk_bf16_f32 v30, v138, v139
    v_lshlrev_b32 v138, 16, v30
    v_and_b32 v139, 0xffff0000, v30
    v_add_f32 v132, v132, v136
    v_add_f32 v133, v133, v137
    v_add_f32 v134, v134, v138
    v_add_f32 v135, v135, v139
    v_cvt_pk_bf16_f32 v128, v132, v133
    v_cvt_pk_bf16_f32 v129, v134, v135
    v_lshlrev_b32 v31, 3, v31
    s_lshl_b32 s11, s5, 10
    s_lshl_b32 s12, s12, 4
    s_add_u32 s11, s11, s12
    s_mov_b32 exec_lo, 0x00010000
    s_mov_b32 exec_hi, 0x00010000
    buffer_store_dwordx2 v[128:129], v31, s[76:79], s11 offen
L_fin:
L_end:
    s_endpgm
.section .rodata,"a"
.p2align 6
.amdhsa_kernel gated_mix__mha_block_cached__sliding_block_cached__decode_kernel
  .amdhsa_next_free_vgpr 256
  .amdhsa_next_free_sgpr 102
  .amdhsa_accum_offset 256
  .amdhsa_group_segment_fixed_size 0
  .amdhsa_kernarg_size 112
  .amdhsa_user_sgpr_count 2
  .amdhsa_user_sgpr_kernarg_segment_ptr 1
  .amdhsa_system_sgpr_workgroup_id_x 1
  .amdhsa_float_denorm_mode_32 3
.end_amdhsa_kernel
```
